```python
import torch

def _softmax(x, axis=-1):
    return torch.softmax(x, dim=axis)
def _gelu(x):
    return torch.nn.functional.gelu(x, approximate="tanh")
def _silu(x):
    return torch.nn.functional.silu(x)
def _sigmoid(x):
    return torch.sigmoid(x)
def _layernorm(x, axis=-1, eps=1e-5):
    m = x.mean(dim=axis, keepdim=True)
    v = x.var(dim=axis, keepdim=True, unbiased=False)
    return (x - m) / torch.sqrt(v + eps)
def _scatter_add(tgt, idx, src, axis=0):
    return tgt.clone().index_add_(axis, idx, src)
def _segment_sum(src, seg, n):
    out = torch.zeros((n,) + src.shape[1:], dtype=src.dtype)
    return out.index_add_(0, seg, src)
def _pad(x, pw):
    flat = tuple(v for pair in reversed(pw) for v in pair)
    return torch.nn.functional.pad(x, flat)

kernel_name = 'standalone__channel_attn_cbam__vision'

def setup_inputs():

    _w = (lambda a: (lambda t: t.to(torch.bfloat16) if t.is_floating_point() else t)(torch.as_tensor(a)))
    H = W = 512
    C = 192
    r = max(C // 4, 1)
    return {
        "x": _w((lambda *s: torch.randn(*s, dtype=torch.bfloat16) * 0.2)(1, H, W, C) + (lambda *s: torch.randn(*s, dtype=torch.bfloat16) * 0.2)(1, 1, 1, C) * 2.0),
        "w1": _w((lambda *s: torch.randn(*s, dtype=torch.bfloat16) * 0.2)(C, r)),
        "w2": _w((lambda *s: torch.randn(*s, dtype=torch.bfloat16) * 0.2)(r, C)),
    }

def reference(x, w1, w2):
    B, H, W, C = x.shape
    xf = x.reshape(B, H * W, C)
    gap = torch.mean(xf, 1)
    gmp = torch.amax(xf, 1)
    h_a = gap @ w1
    h_a = h_a * (lambda x, dt: x.to(dt))(h_a > 0, h_a.dtype)
    h_m = gmp @ w1
    h_m = h_m * (lambda x, dt: x.to(dt))(h_m > 0, h_m.dtype)
    scale = _sigmoid(h_a @ w2 + h_m @ w2)
    return x * scale[:, None, None, :]
```

```asm
; @launch grid=(256,1,1) block=(768,1,1) lds=69632
.amdgcn_target "amdgcn-amd-amdhsa--gfx950"
.text
.globl standalone__channel_attn_cbam__vision_kernel
.p2align 8
.type standalone__channel_attn_cbam__vision_kernel,@function
standalone__channel_attn_cbam__vision_kernel:
    s_load_dwordx2 s[4:5], s[0:1], 0
    s_load_dwordx2 s[8:9], s[0:1], 24
    v_readfirstlane_b32 s28, v0
    v_and_b32 v1, 63, v0
    v_bfe_u32 v2, v0, 3, 3
    v_mul_u32_u24 v2, 384, v2
    v_and_b32 v3, 7, v0
    s_cmpk_ge_u32 s2, 256
    s_cbranch_scc1 L_end
    s_lshl2_add_u32 s35, s28, s2
    s_cmp_le_u32 s35, 32
    s_cbranch_scc1 L_role
L_stream:
    s_lshr_b32 s28, s28, 6
    s_mul_i32 s30, s28, 43
    s_lshr_b32 s30, s30, 7
    s_mul_i32 s34, s30, 21
    s_add_u32 s34, s34, s28
    s_lshl_b32 s34, s34, 7
    v_lshl_add_u32 v0, v3, 4, v2
    v_add_u32 v0, s34, v0
    s_and_b32 s34, s2, 3
    s_bfe_u32 s35, s2, 0x10002
    s_lshl1_add_u32 s34, s34, s35
    s_and_b32 s35, s2, -8
    s_add_u32 s34, s34, s35
    s_mul_i32 s40, s34, 49152
    s_mov_b32 s6, 100663296
    s_mov_b32 s7, 0x20000
    s_waitcnt lgkmcnt(0)
    s_lshr_b32 s34, s8, 7
    s_mul_i32 s34, s34, 21
    s_and_b32 s34, s34, 63
    s_mulk_i32 s34, 384
    s_add_u32 s40, s40, s34
    buffer_load_dwordx4 v[40:43], v0, s[4:7], s40 offen nt
    s_add_u32 s31, s40, 12288
    buffer_load_dwordx4 v[44:47], v0, s[4:7], s31 offen nt
    s_add_u32 s31, s40, 24576
    buffer_load_dwordx4 v[48:51], v0, s[4:7], s31 offen nt
    s_add_u32 s31, s40, 36864
    buffer_load_dwordx4 v[52:55], v0, s[4:7], s31 offen nt
    s_load_dwordx4 s[36:39], s[0:1], 8
    s_load_dwordx2 s[16:17], s[0:1], 32
    s_load_dwordx2 s[12:13], s[0:1], 40
    s_add_u32 s31, s40, 12582912
    buffer_load_dwordx4 v[56:59], v0, s[4:7], s31 offen nt
    s_add_u32 s31, s40, 12595200
    buffer_load_dwordx4 v[60:63], v0, s[4:7], s31 offen nt
    s_add_u32 s31, s40, 12607488
    buffer_load_dwordx4 v[64:67], v0, s[4:7], s31 offen nt
    s_getreg_b32 s34, hwreg(HW_REG_XCC_ID, 0, 3)
    s_lshr_b32 s34, 0x55, s34
    s_and_b64 vcc, s[34:35], 1
    s_add_u32 s31, s40, 12619776
    buffer_load_dwordx4 v[68:71], v0, s[4:7], s31 offen nt
    s_mul_i32 s29, s30, 3
    s_sub_u32 s29, s28, s29
    s_mov_b32 s10, s6
    s_mov_b32 s11, s7
    s_mov_b32 s14, 589952
    s_mov_b32 s15, s7
    s_movk_i32 s18, 256
    s_mov_b32 s19, s7
    s_movk_i32 s51, 24576
    v_bfe_u32 v39, v0, 13, 1
    v_add_u32 v38, 12288, v0
    v_bfe_u32 v38, v38, 13, 1
    v_mul_u32_u24 v39, s51, v39
    v_mul_u32_u24 v38, s51, v38
    s_lshr_b32 s34, s8, 7
    s_mul_i32 s34, s34, 21
    s_and_b32 s34, s34, 63
    s_mulk_i32 s34, 384
    s_lshr_b32 s48, s2, 3
    s_and_b32 s35, s2, 3
    s_lshl2_add_u32 s48, s48, s35
    s_add_u32 s45, s48, 32
    s_and_b32 s45, s45, 127
    s_mul_i32 s48, s48, 98304
    s_add_u32 s48, s48, s34
    s_mul_i32 s45, s45, 98304
    s_add_u32 s45, s45, s34
    s_add_u32 s45, s45, 49152
    s_add_u32 s51, s51, s8
    s_add_u32 s34, s48, s51
    s_bfe_i32 s49, s34, 0x10015
    s_add_u32 s51, s45, s51
    s_xor_b32 s34, s34, s51
    s_bfe_i32 s34, s34, 0x10015
    s_and_b32 s34, s34, 43690
    s_xor_b32 s49, s49, s34
    s_cmp_lt_u32 s48, 4169728
    s_cselect_b32 s34, 1024, 0
    s_or_b32 s34, s34, 960
    s_cmp_lt_u32 s45, 4169728
    s_cselect_b32 s35, 2048, 0
    s_or_b32 s34, s34, s35
    s_xor_b32 s35, s34, 65472
    s_lshr_b32 s50, s2, 3
    s_mul_i32 s51, s50, 52
    s_lshr_b32 s51, s51, 8
    s_mul_i32 s51, s51, 5
    s_sub_u32 s50, s50, s51
    s_lshr_b32 s50, 1385473321, s50
    s_sub_u32 s51, s8, s4
    s_add_u32 s51, s51, 2048
    s_bitcmp1_b32 s51, 12
    s_cselect_b32 s50, 0, s50
    s_cselect_b32 s44, 0, 8388608
    s_or_b32 s44, s44, 537004288
    s_lshr_b32 s51, s2, 3
    s_sub_u32 s42, s51, 8
    s_and_b32 s43, s2, 7
    s_lshl_b32 s43, s43, 5
    s_add_u32 s43, s43, s51
    s_mulk_i32 s43, 1536
    v_and_b32 v20, 1, v1
    v_lshlrev_b32 v20, 4, v20
    v_mov_b32 v21, 0x3f80
    v_lshlrev_b32 v20, v20, v21
    v_bfe_u32 v21, v1, 1, 3
    v_cmp_eq_u32 s[24:25], 0, v21
    s_nop 1
    v_cndmask_b32 v8, 0, v20, s[24:25]
    v_cmp_eq_u32 s[24:25], 2, v21
    s_nop 1
    v_cndmask_b32 v9, 0, v20, s[24:25]
    v_cmp_eq_u32 s[24:25], 4, v21
    s_nop 1
    v_cndmask_b32 v10, 0, v20, s[24:25]
    v_cmp_eq_u32 s[24:25], 6, v21
    s_nop 1
    v_cndmask_b32 v11, 0, v20, s[24:25]
    v_mov_b32 v20, 0
    v_lshlrev_b32 v21, 2, v1
    s_mov_b64 exec, 7
    ds_write_b32 v21, v20 offset:6336
    s_mov_b64 exec, -1
    s_add_u32 s31, s40, 25165824
    buffer_load_dwordx4 v[72:75], v0, s[4:7], s31 offen nt
    s_add_u32 s31, s40, 25178112
    buffer_load_dwordx4 v[76:79], v0, s[4:7], s31 offen nt
    s_add_u32 s31, s40, 25190400
    buffer_load_dwordx4 v[80:83], v0, s[4:7], s31 offen nt
    s_add_u32 s31, s40, 25202688
    buffer_load_dwordx4 v[84:87], v0, s[4:7], s31 offen nt
    s_waitcnt lgkmcnt(0)
    s_barrier
    s_load_dword s51, s[16:17], 0
    s_waitcnt lgkmcnt(0)
    s_andn2_b32 s33, s44, s51
    s_cbranch_scc1 L_dpoll
L_decided:
    s_bitcmp1_b32 s51, 12
    s_cselect_b32 s24, s34, 0
    s_bitcmp1_b32 s51, 18
    s_cselect_b32 s25, s34, 0
    s_bitcmp1_b32 s51, 24
    s_cselect_b32 s26, s35, 0
    s_bitcmp1_b32 s51, 30
    s_cselect_b32 s27, s35, 0
    s_or_b32 s24, s24, s26
    s_or_b32 s25, s25, s27
    s_xor_b32 s24, s24, s25
    s_and_b32 s24, s24, s50
    s_xor_b32 s24, s24, s25
    s_xor_b32 s49, s49, s24
    s_lshr_b32 s1, s51, 13
    s_add_u32 s1, s1, s2
    s_bfe_i32 s24, s1, 0x10002
    s_xor_b32 s49, s49, s24
    s_and_b32 s41, s51, 15
    s_bfe_u32 s47, s51, 0x40004
    s_xor_b32 s3, s41, 15
    s_xor_b32 s0, s47, 15
    s_lshr_b32 s24, s51, 10
    s_and_b32 s24, s24, 4
    s_xor_b32 s1, s1, s24
    s_load_dword s22, s[36:37], 0
    s_load_dword s23, s[38:39], 0
    s_cbranch_vccz L_thr12
    s_waitcnt vmcnt(1)
L_thr12:
    s_bitcmp1_b32 s49, 6
    s_cselect_b32 s50, 24576, 0
    s_add_u32 s31, s48, 37748736
    v_xad_u32 v2, v39, s50, v0
    buffer_load_dwordx4 v[88:91], v2, s[4:7], s31 offen nt
    s_cbranch_vccz L_thr13
    s_waitcnt vmcnt(1)
L_thr13:
    s_add_u32 s31, s48, 37761024
    v_xad_u32 v3, v38, s50, v0
    buffer_load_dwordx4 v[92:95], v3, s[4:7], s31 offen nt
    s_branch L_skip1
    .p2align 7
L_role:
    s_load_dwordx4 s[44:47], s[0:1], 32
    s_lshr_b32 s25, s2, 3
    s_and_b32 s35, s2, 1
    s_lshl1_add_u32 s35, s35, 1
    s_mul_i32 s51, s2, 0x104100
    s_cmp_eq_u32 s2, 32
    s_waitcnt lgkmcnt(0)
    s_cbranch_scc1 L_tag
    s_sub_u32 s34, s8, s4
    s_addk_i32 s34, 2048
    s_bitcmp1_b32 s34, 12
    s_cselect_b32 s24, 7, 5
    s_cselect_b32 s26, s25, 1
    s_cmp_eq_u32 s26, 2
    s_cselect_b32 s25, s35, s25
    s_bitcmp1_b32 s25, 0
    s_cselect_b64 s[20:21], s[8:9], s[4:5]
    s_lshr_b32 s35, s25, 1
    s_lshl_b32 s35, 0x2000000, s35
    s_add_u32 s51, s51, s35
    s_lshr_b32 s34, s8, 7
    s_mul_i32 s34, s34, 21
    s_and_b32 s34, s34, 63
    s_mulk_i32 s34, 384
    s_add_u32 s34, s34, s51
    s_cmp_lg_u32 s26, 0
    s_cselect_b32 s27, s8, 0
    s_cbranch_scc1 L_notws
    s_mov_b64 s[20:21], s[46:47]
    s_mov_b32 s24, 4
    s_and_b32 s34, s51, 0xfffff
    s_add_u32 s34, s34, 655360
L_notws:
    s_add_u32 s35, s34, 8192
    s_load_dword s42, s[20:21], s34 glc
    s_load_dword s43, s[20:21], s35 glc
    s_mov_b32 s33, -1
    s_waitcnt lgkmcnt(0)
    s_load_dword s42, s[20:21], s34 glc
    s_load_dword s43, s[20:21], s35 glc
    s_waitcnt lgkmcnt(1)
    s_nop 7
    s_getreg_b32 s51, hwreg(HW_REG_IB_STS, 8, 4)
    s_xor_b32 s51, s51, 1
    s_add_u32 s33, s33, s51
    s_waitcnt lgkmcnt(0)
    s_load_dword s42, s[20:21], s35 glc
    s_load_dword s43, s[20:21], s34 glc
    s_waitcnt lgkmcnt(1)
    s_nop 7
    s_getreg_b32 s51, hwreg(HW_REG_IB_STS, 8, 4)
    s_add_u32 s33, s33, s51
    s_sub_u32 s51, 0, s33
    s_add_u32 s34, s34, s27
    s_lshr_b32 s34, s34, 19
    s_getreg_b32 s35, hwreg(HW_REG_XCC_ID, 0, 3)
    s_xor_b32 s34, s34, s35
    s_bitcmp1_b32 s34, 2
    s_cselect_b32 s33, s51, s33
    s_lshl_b32 s33, s33, 8
    s_or_b32 s33, s33, 1
    s_mov_b32 s35, s33
    s_lshl2_add_u32 s34, s25, 128
    s_atomic_add s35, s[44:45], s34 glc
    s_mul_i32 s51, s25, 6
    s_waitcnt lgkmcnt(0)
    s_add_u32 s35, s35, s33
    s_and_b32 s34, s35, 0xff
    s_cmp_lg_u32 s34, s24
    s_cbranch_scc1 L_stream
    s_cmp_gt_i32 s35, 0xff
    s_cselect_b32 s35, 3, 1
    s_add_u32 s51, s51, 11
    s_lshl_b32 s35, s35, s51
L_publish:
    s_atomic_add s35, s[44:45], 0
    s_waitcnt lgkmcnt(0)
    s_branch L_stream
L_tag:
    s_mov_b32 s35, 1
    s_waitcnt lgkmcnt(0)
    s_atomic_add s35, s[46:47], 589824 glc
    s_waitcnt lgkmcnt(0)
    s_add_u32 s35, s35, 1
    s_and_b32 s35, s35, 0xff
    s_bitset1_b32 s35, 8
    s_getreg_b32 s34, hwreg(HW_REG_XCC_ID, 0, 3)
    s_lshl_b32 s34, s34, 13
    s_or_b32 s35, s35, s34
    s_branch L_publish
L_dpoll:
    s_mov_b32 s33, 2000000
    v_mov_b32 v36, 0
    s_mov_b64 exec, 1
L_dloop:
    buffer_load_dword v36, off, s[16:19], 0 offset:0 sc1
    s_sleep 8
    s_waitcnt vmcnt(24)
    v_readfirstlane_b32 s51, v36
    s_sub_u32 s33, s33, 1
    s_cbranch_scc1 L_dgot
    s_andn2_b32 s31, s44, s51
    s_cbranch_scc1 L_dloop
L_dgot:
    s_mov_b64 exec, -1
    s_branch L_decided
L_skip1:
    s_waitcnt vmcnt(12)
    v_mfma_f32_16x16x32_bf16 v[4:7], v[8:11], v[40:43], 0
    v_lshlrev_b32 v20, 16, v40
    v_lshlrev_b32 v22, 16, v41
    v_lshlrev_b32 v24, 16, v42
    v_lshlrev_b32 v26, 16, v43
    v_mfma_f32_16x16x32_bf16 v[4:7], v[8:11], v[44:47], v[4:7]
    v_lshlrev_b32 v21, 16, v44
    v_lshlrev_b32 v23, 16, v45
    v_lshlrev_b32 v25, 16, v46
    v_lshlrev_b32 v27, 16, v47
    v_max_f32 v13, v40, v44
    v_max_f32 v15, v41, v45
    v_max_f32 v17, v42, v46
    v_max_f32 v19, v43, v47
    v_max_f32 v12, v20, v21
    v_max_f32 v14, v22, v23
    v_max_f32 v16, v24, v25
    v_max_f32 v18, v26, v27
    s_waitcnt vmcnt(10)
    v_mfma_f32_16x16x32_bf16 v[4:7], v[8:11], v[48:51], v[4:7]
    v_lshlrev_b32 v20, 16, v48
    v_lshlrev_b32 v22, 16, v49
    v_lshlrev_b32 v24, 16, v50
    v_lshlrev_b32 v26, 16, v51
    v_mfma_f32_16x16x32_bf16 v[4:7], v[8:11], v[52:55], v[4:7]
    v_lshlrev_b32 v21, 16, v52
    v_lshlrev_b32 v23, 16, v53
    v_lshlrev_b32 v25, 16, v54
    v_lshlrev_b32 v27, 16, v55
    v_max3_f32 v13, v13, v48, v52
    v_max3_f32 v15, v15, v49, v53
    v_max3_f32 v17, v17, v50, v54
    v_max3_f32 v19, v19, v51, v55
    v_max3_f32 v12, v12, v20, v21
    v_max3_f32 v14, v14, v22, v23
    v_max3_f32 v16, v16, v24, v25
    v_max3_f32 v18, v18, v26, v27
    s_cbranch_vccz L_thr14
    s_waitcnt vmcnt(1)
L_thr14:
    s_bitcmp1_b32 s49, 7
    s_cselect_b32 s50, 24576, 0
    s_add_u32 s31, s45, 37748736
    v_xad_u32 v2, v39, s50, v0
    buffer_load_dwordx4 v[96:99], v2, s[4:7], s31 offen nt
    s_cbranch_vccz L_thr15
    s_waitcnt vmcnt(1)
L_thr15:
    s_add_u32 s31, s45, 37761024
    v_xad_u32 v3, v38, s50, v0
    buffer_load_dwordx4 v[100:103], v3, s[4:7], s31 offen nt
    s_waitcnt vmcnt(10)
    v_mfma_f32_16x16x32_bf16 v[4:7], v[8:11], v[56:59], v[4:7]
    v_lshlrev_b32 v20, 16, v56
    v_lshlrev_b32 v22, 16, v57
    v_lshlrev_b32 v24, 16, v58
    v_lshlrev_b32 v26, 16, v59
    v_mfma_f32_16x16x32_bf16 v[4:7], v[8:11], v[60:63], v[4:7]
    v_lshlrev_b32 v21, 16, v60
    v_lshlrev_b32 v23, 16, v61
    v_lshlrev_b32 v25, 16, v62
    v_lshlrev_b32 v27, 16, v63
    v_max3_f32 v13, v13, v56, v60
    v_max3_f32 v15, v15, v57, v61
    v_max3_f32 v17, v17, v58, v62
    v_max3_f32 v19, v19, v59, v63
    v_max3_f32 v12, v12, v20, v21
    v_max3_f32 v14, v14, v22, v23
    v_max3_f32 v16, v16, v24, v25
    v_max3_f32 v18, v18, v26, v27
    s_cbranch_vccz L_thr16
    s_waitcnt vmcnt(1)
L_thr16:
    s_bitcmp1_b32 s49, 8
    s_cselect_b32 s50, 24576, 0
    s_add_u32 s31, s48, 50331648
    v_xad_u32 v2, v39, s50, v0
    buffer_load_dwordx4 v[104:107], v2, s[4:7], s31 offen nt
    s_cbranch_vccz L_thr17
    s_waitcnt vmcnt(1)
L_thr17:
    s_add_u32 s31, s48, 50343936
    v_xad_u32 v3, v38, s50, v0
    buffer_load_dwordx4 v[108:111], v3, s[4:7], s31 offen nt
    s_waitcnt vmcnt(10)
    v_mfma_f32_16x16x32_bf16 v[4:7], v[8:11], v[64:67], v[4:7]
    v_lshlrev_b32 v20, 16, v64
    v_lshlrev_b32 v22, 16, v65
    v_lshlrev_b32 v24, 16, v66
    v_lshlrev_b32 v26, 16, v67
    v_mfma_f32_16x16x32_bf16 v[4:7], v[8:11], v[68:71], v[4:7]
    v_lshlrev_b32 v21, 16, v68
    v_lshlrev_b32 v23, 16, v69
    v_lshlrev_b32 v25, 16, v70
    v_lshlrev_b32 v27, 16, v71
    v_max3_f32 v13, v13, v64, v68
    v_max3_f32 v15, v15, v65, v69
    v_max3_f32 v17, v17, v66, v70
    v_max3_f32 v19, v19, v67, v71
    v_max3_f32 v12, v12, v20, v21
    v_max3_f32 v14, v14, v22, v23
    v_max3_f32 v16, v16, v24, v25
    v_max3_f32 v18, v18, v26, v27
    s_cbranch_vccz L_thr18
    s_waitcnt vmcnt(1)
L_thr18:
    s_bitcmp1_b32 s49, 9
    s_cselect_b32 s50, 24576, 0
    s_add_u32 s31, s45, 50331648
    v_xad_u32 v2, v39, s50, v0
    buffer_load_dwordx4 v[112:115], v2, s[4:7], s31 offen nt
    s_cbranch_vccz L_thr19
    s_waitcnt vmcnt(1)
L_thr19:
    s_add_u32 s31, s45, 50343936
    v_xad_u32 v3, v38, s50, v0
    buffer_load_dwordx4 v[116:119], v3, s[4:7], s31 offen nt
    s_waitcnt vmcnt(10)
    v_mfma_f32_16x16x32_bf16 v[4:7], v[8:11], v[72:75], v[4:7]
    v_lshlrev_b32 v20, 16, v72
    v_lshlrev_b32 v22, 16, v73
    v_lshlrev_b32 v24, 16, v74
    v_lshlrev_b32 v26, 16, v75
    v_mfma_f32_16x16x32_bf16 v[4:7], v[8:11], v[76:79], v[4:7]
    v_lshlrev_b32 v21, 16, v76
    v_lshlrev_b32 v23, 16, v77
    v_lshlrev_b32 v25, 16, v78
    v_lshlrev_b32 v27, 16, v79
    v_max3_f32 v13, v13, v72, v76
    v_max3_f32 v15, v15, v73, v77
    v_max3_f32 v17, v17, v74, v78
    v_max3_f32 v19, v19, v75, v79
    v_max3_f32 v12, v12, v20, v21
    v_max3_f32 v14, v14, v22, v23
    v_max3_f32 v16, v16, v24, v25
    v_max3_f32 v18, v18, v26, v27
    s_barrier
    s_cbranch_vccz L_thr20
    s_waitcnt vmcnt(1)
L_thr20:
    s_bitcmp1_b32 s49, 10
    s_cselect_b32 s50, 24576, 0
    s_add_u32 s31, s48, 62914560
    v_xad_u32 v2, v39, s50, v0
    buffer_load_dwordx4 v[120:123], v2, s[4:7], s31 offen nt
    s_cbranch_vccz L_thr21
    s_waitcnt vmcnt(1)
L_thr21:
    s_add_u32 s31, s48, 62926848
    v_xad_u32 v3, v38, s50, v0
    buffer_load_dwordx4 v[124:127], v3, s[4:7], s31 offen nt
    s_waitcnt vmcnt(10)
    v_mfma_f32_16x16x32_bf16 v[4:7], v[8:11], v[80:83], v[4:7]
    v_lshlrev_b32 v20, 16, v80
    v_lshlrev_b32 v22, 16, v81
    v_lshlrev_b32 v24, 16, v82
    v_lshlrev_b32 v26, 16, v83
    v_mfma_f32_16x16x32_bf16 v[4:7], v[8:11], v[84:87], v[4:7]
    v_lshlrev_b32 v21, 16, v84
    v_lshlrev_b32 v23, 16, v85
    v_lshlrev_b32 v25, 16, v86
    v_lshlrev_b32 v27, 16, v87
    v_max3_f32 v13, v13, v80, v84
    v_max3_f32 v15, v15, v81, v85
    v_max3_f32 v17, v17, v82, v86
    v_max3_f32 v19, v19, v83, v87
    v_max3_f32 v12, v12, v20, v21
    v_max3_f32 v14, v14, v22, v23
    v_max3_f32 v16, v16, v24, v25
    v_max3_f32 v18, v18, v26, v27
    s_cbranch_vccz L_thr22
    s_waitcnt vmcnt(1)
L_thr22:
    s_bitcmp1_b32 s49, 11
    s_cselect_b32 s50, 24576, 0
    s_add_u32 s31, s45, 62914560
    v_xad_u32 v2, v39, s50, v0
    buffer_load_dwordx4 v[128:131], v2, s[4:7], s31 offen nt
    s_cbranch_vccz L_thr23
    s_waitcnt vmcnt(1)
L_thr23:
    s_add_u32 s31, s45, 62926848
    v_xad_u32 v3, v38, s50, v0
    buffer_load_dwordx4 v[132:135], v3, s[4:7], s31 offen nt
    s_waitcnt vmcnt(10)
    v_mfma_f32_16x16x32_bf16 v[4:7], v[8:11], v[88:91], v[4:7]
    v_lshlrev_b32 v20, 16, v88
    v_lshlrev_b32 v22, 16, v89
    v_lshlrev_b32 v24, 16, v90
    v_lshlrev_b32 v26, 16, v91
    v_mfma_f32_16x16x32_bf16 v[4:7], v[8:11], v[92:95], v[4:7]
    v_lshlrev_b32 v21, 16, v92
    v_lshlrev_b32 v23, 16, v93
    v_lshlrev_b32 v25, 16, v94
    v_lshlrev_b32 v27, 16, v95
    v_max3_f32 v13, v13, v88, v92
    v_max3_f32 v15, v15, v89, v93
    v_max3_f32 v17, v17, v90, v94
    v_max3_f32 v19, v19, v91, v95
    v_max3_f32 v12, v12, v20, v21
    v_max3_f32 v14, v14, v22, v23
    v_max3_f32 v16, v16, v24, v25
    v_max3_f32 v18, v18, v26, v27
    s_barrier
    s_cbranch_vccz L_thr24
    s_waitcnt vmcnt(1)
L_thr24:
    s_bitcmp1_b32 s49, 12
    s_cselect_b32 s50, 24576, 0
    s_add_u32 s31, s48, 75497472
    v_xad_u32 v2, v39, s50, v0
    buffer_load_dwordx4 v[136:139], v2, s[4:7], s31 offen nt
    s_cbranch_vccz L_thr25
    s_waitcnt vmcnt(1)
L_thr25:
    s_add_u32 s31, s48, 75509760
    v_xad_u32 v3, v38, s50, v0
    buffer_load_dwordx4 v[140:143], v3, s[4:7], s31 offen nt
    s_waitcnt vmcnt(10)
    v_mfma_f32_16x16x32_bf16 v[4:7], v[8:11], v[96:99], v[4:7]
    v_lshlrev_b32 v20, 16, v96
    v_lshlrev_b32 v22, 16, v97
    v_lshlrev_b32 v24, 16, v98
    v_lshlrev_b32 v26, 16, v99
    v_mfma_f32_16x16x32_bf16 v[4:7], v[8:11], v[100:103], v[4:7]
    v_lshlrev_b32 v21, 16, v100
    v_lshlrev_b32 v23, 16, v101
    v_lshlrev_b32 v25, 16, v102
    v_lshlrev_b32 v27, 16, v103
    v_max3_f32 v13, v13, v96, v100
    v_max3_f32 v15, v15, v97, v101
    v_max3_f32 v17, v17, v98, v102
    v_max3_f32 v19, v19, v99, v103
    v_max3_f32 v12, v12, v20, v21
    v_max3_f32 v14, v14, v22, v23
    v_max3_f32 v16, v16, v24, v25
    v_max3_f32 v18, v18, v26, v27
    s_bitcmp1_b32 s49, 13
    s_cselect_b32 s50, 24576, 0
    s_add_u32 s31, s45, 75497472
    v_xad_u32 v2, v39, s50, v0
    buffer_load_dwordx4 v[144:147], v2, s[4:7], s31 offen nt
    s_add_u32 s31, s45, 75509760
    v_xad_u32 v3, v38, s50, v0
    buffer_load_dwordx4 v[148:151], v3, s[4:7], s31 offen nt
    s_waitcnt vmcnt(10)
    v_mfma_f32_16x16x32_bf16 v[4:7], v[8:11], v[104:107], v[4:7]
    v_lshlrev_b32 v20, 16, v104
    v_lshlrev_b32 v22, 16, v105
    v_lshlrev_b32 v24, 16, v106
    v_lshlrev_b32 v26, 16, v107
    v_mfma_f32_16x16x32_bf16 v[4:7], v[8:11], v[108:111], v[4:7]
    v_lshlrev_b32 v21, 16, v108
    v_lshlrev_b32 v23, 16, v109
    v_lshlrev_b32 v25, 16, v110
    v_lshlrev_b32 v27, 16, v111
    v_max3_f32 v13, v13, v104, v108
    v_max3_f32 v15, v15, v105, v109
    v_max3_f32 v17, v17, v106, v110
    v_max3_f32 v19, v19, v107, v111
    v_max3_f32 v12, v12, v20, v21
    v_max3_f32 v14, v14, v22, v23
    v_max3_f32 v16, v16, v24, v25
    v_max3_f32 v18, v18, v26, v27
    s_bitcmp1_b32 s49, 14
    s_cselect_b32 s50, 24576, 0
    s_add_u32 s31, s48, 88080384
    v_xad_u32 v2, v39, s50, v0
    buffer_load_dwordx4 v[152:155], v2, s[4:7], s31 offen nt
    s_add_u32 s31, s48, 88092672
    v_xad_u32 v3, v38, s50, v0
    buffer_load_dwordx4 v[156:159], v3, s[4:7], s31 offen nt
    s_waitcnt vmcnt(10)
    v_mfma_f32_16x16x32_bf16 v[4:7], v[8:11], v[112:115], v[4:7]
    v_lshlrev_b32 v20, 16, v112
    v_lshlrev_b32 v22, 16, v113
    v_lshlrev_b32 v24, 16, v114
    v_lshlrev_b32 v26, 16, v115
    v_mfma_f32_16x16x32_bf16 v[4:7], v[8:11], v[116:119], v[4:7]
    v_lshlrev_b32 v21, 16, v116
    v_lshlrev_b32 v23, 16, v117
    v_lshlrev_b32 v25, 16, v118
    v_lshlrev_b32 v27, 16, v119
    v_max3_f32 v13, v13, v112, v116
    v_max3_f32 v15, v15, v113, v117
    v_max3_f32 v17, v17, v114, v118
    v_max3_f32 v19, v19, v115, v119
    v_max3_f32 v12, v12, v20, v21
    v_max3_f32 v14, v14, v22, v23
    v_max3_f32 v16, v16, v24, v25
    v_max3_f32 v18, v18, v26, v27
    s_cmp_lg_u32 s28, 4
    s_cbranch_scc1 L_nowarm
    v_lshlrev_b32 v3, 7, v1
    s_mov_b64 exec, 0xfff
    buffer_load_dword v37, v3, s[12:15], s43 offen
    s_mov_b64 exec, -1
L_nowarm:
    s_bitcmp1_b32 s49, 15
    s_cselect_b32 s50, 24576, 0
    s_add_u32 s31, s45, 88080384
    v_xad_u32 v2, v39, s50, v0
    v_add_u32 v2, s31, v2
    v_subrev_u32 v3, s6, v2
    v_min_u32 v2, v2, v3
    buffer_load_dwordx4 v[160:163], v2, s[4:7], 0 offen nt
    s_add_u32 s31, s45, 88092672
    v_xad_u32 v3, v38, s50, v0
    v_add_u32 v3, s31, v3
    v_subrev_u32 v2, s6, v3
    v_min_u32 v3, v3, v2
    buffer_load_dwordx4 v[164:167], v3, s[4:7], 0 offen nt
    s_waitcnt vmcnt(10)
    v_mfma_f32_16x16x32_bf16 v[4:7], v[8:11], v[120:123], v[4:7]
    v_lshlrev_b32 v20, 16, v120
    v_lshlrev_b32 v22, 16, v121
    v_lshlrev_b32 v24, 16, v122
    v_lshlrev_b32 v26, 16, v123
    v_mfma_f32_16x16x32_bf16 v[4:7], v[8:11], v[124:127], v[4:7]
    v_lshlrev_b32 v21, 16, v124
    v_lshlrev_b32 v23, 16, v125
    v_lshlrev_b32 v25, 16, v126
    v_lshlrev_b32 v27, 16, v127
    v_max3_f32 v13, v13, v120, v124
    v_max3_f32 v15, v15, v121, v125
    v_max3_f32 v17, v17, v122, v126
    v_max3_f32 v19, v19, v123, v127
    v_max3_f32 v12, v12, v20, v21
    v_max3_f32 v14, v14, v22, v23
    v_max3_f32 v16, v16, v24, v25
    v_max3_f32 v18, v18, v26, v27
    s_waitcnt vmcnt(8)
    v_mfma_f32_16x16x32_bf16 v[4:7], v[8:11], v[128:131], v[4:7]
    v_lshlrev_b32 v20, 16, v128
    v_lshlrev_b32 v22, 16, v129
    v_lshlrev_b32 v24, 16, v130
    v_lshlrev_b32 v26, 16, v131
    v_mfma_f32_16x16x32_bf16 v[4:7], v[8:11], v[132:135], v[4:7]
    v_lshlrev_b32 v21, 16, v132
    v_lshlrev_b32 v23, 16, v133
    v_lshlrev_b32 v25, 16, v134
    v_lshlrev_b32 v27, 16, v135
    v_max3_f32 v13, v13, v128, v132
    v_max3_f32 v15, v15, v129, v133
    v_max3_f32 v17, v17, v130, v134
    v_max3_f32 v19, v19, v131, v135
    v_max3_f32 v12, v12, v20, v21
    v_max3_f32 v14, v14, v22, v23
    v_max3_f32 v16, v16, v24, v25
    v_max3_f32 v18, v18, v26, v27
    s_waitcnt vmcnt(6)
    v_mfma_f32_16x16x32_bf16 v[4:7], v[8:11], v[136:139], v[4:7]
    v_lshlrev_b32 v20, 16, v136
    v_lshlrev_b32 v22, 16, v137
    v_lshlrev_b32 v24, 16, v138
    v_lshlrev_b32 v26, 16, v139
    v_mfma_f32_16x16x32_bf16 v[4:7], v[8:11], v[140:143], v[4:7]
    v_lshlrev_b32 v21, 16, v140
    v_lshlrev_b32 v23, 16, v141
    v_lshlrev_b32 v25, 16, v142
    v_lshlrev_b32 v27, 16, v143
    v_max3_f32 v13, v13, v136, v140
    v_max3_f32 v15, v15, v137, v141
    v_max3_f32 v17, v17, v138, v142
    v_max3_f32 v19, v19, v139, v143
    v_max3_f32 v12, v12, v20, v21
    v_max3_f32 v14, v14, v22, v23
    v_max3_f32 v16, v16, v24, v25
    v_max3_f32 v18, v18, v26, v27
    s_waitcnt vmcnt(4)
    v_mfma_f32_16x16x32_bf16 v[4:7], v[8:11], v[144:147], v[4:7]
    v_lshlrev_b32 v20, 16, v144
    v_lshlrev_b32 v22, 16, v145
    v_lshlrev_b32 v24, 16, v146
    v_lshlrev_b32 v26, 16, v147
    v_mfma_f32_16x16x32_bf16 v[4:7], v[8:11], v[148:151], v[4:7]
    v_lshlrev_b32 v21, 16, v148
    v_lshlrev_b32 v23, 16, v149
    v_lshlrev_b32 v25, 16, v150
    v_lshlrev_b32 v27, 16, v151
    v_max3_f32 v13, v13, v144, v148
    v_max3_f32 v15, v15, v145, v149
    v_max3_f32 v17, v17, v146, v150
    v_max3_f32 v19, v19, v147, v151
    v_max3_f32 v12, v12, v20, v21
    v_max3_f32 v14, v14, v22, v23
    v_max3_f32 v16, v16, v24, v25
    v_max3_f32 v18, v18, v26, v27
    s_waitcnt vmcnt(2)
    v_mfma_f32_16x16x32_bf16 v[4:7], v[8:11], v[152:155], v[4:7]
    v_lshlrev_b32 v20, 16, v152
    v_lshlrev_b32 v22, 16, v153
    v_lshlrev_b32 v24, 16, v154
    v_lshlrev_b32 v26, 16, v155
    v_mfma_f32_16x16x32_bf16 v[4:7], v[8:11], v[156:159], v[4:7]
    v_lshlrev_b32 v21, 16, v156
    v_lshlrev_b32 v23, 16, v157
    v_lshlrev_b32 v25, 16, v158
    v_lshlrev_b32 v27, 16, v159
    v_max3_f32 v13, v13, v152, v156
    v_max3_f32 v15, v15, v153, v157
    v_max3_f32 v17, v17, v154, v158
    v_max3_f32 v19, v19, v155, v159
    v_max3_f32 v12, v12, v20, v21
    v_max3_f32 v14, v14, v22, v23
    v_max3_f32 v16, v16, v24, v25
    v_max3_f32 v18, v18, v26, v27
    s_branch L_tail
L_rlong:
    s_waitcnt vmcnt(0)
    s_cmp_lg_u32 s46, 0
    s_cbranch_scc1 L_rgot
    s_call_b64 s[38:39], L_flush
    s_branch L_rpoll
L_qlong0:
    s_waitcnt vmcnt(0)
    s_cmp_lg_u32 s46, 0
    s_cbranch_scc1 L_qgot0
    s_call_b64 s[38:39], L_flush
    s_branch L_qpoll0
L_qlong1:
    s_waitcnt vmcnt(0)
    s_cmp_lg_u32 s46, 0
    s_cbranch_scc1 L_qgot1
    s_call_b64 s[38:39], L_flush
    s_branch L_qpoll1
L_flush:
    s_mov_b32 s33, 2000000
    s_mov_b32 s46, 2000000
    s_mov_b32 exec_lo, -1
    s_mov_b32 exec_hi, 0xffff
    v_lshlrev_b32 v21, 4, v1
L_floop:
    buffer_load_dwordx4 v[8:11], v21, s[12:15], s43 offen sc1
    buffer_load_dwordx4 v[4:7], v21, s[12:15], s43 offen offset:768 sc1
    s_sub_u32 s46, s46, 1
    s_waitcnt vmcnt(0)
    v_xor_b32 v15, s41, v8
    v_bitop3_b32 v15, v15, v9, s47 bitop3:0xf6
    v_bitop3_b32 v15, v15, v10, s3 bitop3:0xf6
    v_bitop3_b32 v15, v15, v11, s0 bitop3:0xf6
    v_bitop3_b32 v15, v15, v4, s41 bitop3:0xf6
    v_bitop3_b32 v15, v15, v5, s47 bitop3:0xf6
    v_bitop3_b32 v15, v15, v6, s3 bitop3:0xf6
    v_bitop3_b32 v15, v15, v7, s0 bitop3:0xf6
    v_and_b32 v15, 15, v15
    v_cmp_ne_u32 vcc, 0, v15
    s_cbranch_scc1 L_fdone
    s_cbranch_vccnz L_floop
L_fdone:
    buffer_store_dwordx4 v[8:11], v21, s[12:15], s43 offen sc1
    buffer_store_dwordx4 v[4:7], v21, s[12:15], s43 offen offset:768 sc1
    s_waitcnt vmcnt(0)
    s_mov_b64 exec, -1
    s_mov_b32 s46, -1
    s_setpc_b64 s[38:39]
    .p2align 12
L_tail:
    s_lshl_b32 s34, s29, 11
    v_lshl_add_u32 v3, v1, 3, s34
    s_lshl_b32 s34, s30, 9
    v_add_u32 v2, s34, v3
    s_lshl2_add_u32 s34, s29, 6336
    v_mov_b32 v28, s34
    v_mov_b32 v29, 1
    v_and_b32 v30, 7, v1
    v_lshrrev_b32 v31, 4, v1
    v_lshl_add_u32 v30, v31, 3, v30
    v_bfe_u32 v31, v1, 3, 1
    v_mul_u32_u24 v31, 96, v31
    s_lshl_b32 s34, s29, 5
    v_add3_u32 v30, v30, v31, s34
    v_lshlrev_b32 v30, 3, v30
    v_bfe_i32 v31, v1, 0, 1
    v_and_b32 v31, 15, v31
    v_xor_b32 v32, s47, v31
    v_xor_b32 v31, s41, v31
    v_bfe_i32 v33, v1, 3, 1
    v_and_b32 v33, 0xfff0, v33
    v_xor_b32 v33, -16, v33
    s_waitcnt vmcnt(0)
    v_mfma_f32_16x16x32_bf16 v[4:7], v[8:11], v[160:163], v[4:7]
    v_lshlrev_b32 v20, 16, v160
    v_lshlrev_b32 v22, 16, v161
    v_lshlrev_b32 v24, 16, v162
    v_lshlrev_b32 v26, 16, v163
    v_mfma_f32_16x16x32_bf16 v[4:7], v[8:11], v[164:167], v[4:7]
    v_lshlrev_b32 v21, 16, v164
    v_lshlrev_b32 v23, 16, v165
    v_lshlrev_b32 v25, 16, v166
    v_lshlrev_b32 v27, 16, v167
    v_max3_f32 v13, v13, v160, v164
    v_max3_f32 v15, v15, v161, v165
    v_max3_f32 v17, v17, v162, v166
    v_max3_f32 v19, v19, v163, v167
    v_max3_f32 v12, v12, v20, v21
    v_max3_f32 v14, v14, v22, v23
    v_max3_f32 v16, v16, v24, v25
    v_max3_f32 v18, v18, v26, v27
    v_permlane32_swap_b32 v13, v17
    v_permlane32_swap_b32 v15, v19
    v_permlane32_swap_b32 v12, v16
    v_permlane32_swap_b32 v14, v18
    v_max_f32 v13, v13, v17
    v_max_f32 v15, v15, v19
    v_max_f32 v12, v12, v16
    v_max_f32 v14, v14, v18
    v_permlane16_swap_b32 v13, v15
    s_nop 0
    v_permlane16_swap_b32 v12, v14
    v_max_f32 v13, v13, v15
    v_max_f32 v12, v12, v14
    s_cmp_ge_u32 s28, 2
    v_add_f32_dpp v4, v4, v4 row_ror:8 row_mask:0xf bank_mask:0x3
    v_add_f32_dpp v5, v5, v5 row_ror:8 row_mask:0xf bank_mask:0x3
    v_max_f32_dpp v4, v12, v12 row_ror:8 row_mask:0xf bank_mask:0xc
    v_max_f32_dpp v5, v13, v13 row_ror:8 row_mask:0xf bank_mask:0xc
    ds_write_b64 v2, v[4:5] offset:0
    s_mov_b64 exec, 1
    ds_add_rtn_u32 v6, v28, v29
    s_mov_b64 exec, -1
    ds_read2st64_b64 v[8:11], v3 offset0:0 offset1:1
    ds_read2st64_b64 v[12:15], v3 offset0:2 offset1:3
    s_waitcnt lgkmcnt(1)
    v_readfirstlane_b32 s34, v6
    v_pk_add_f32 v[4:5], v[8:9], v[10:11]
    s_waitcnt lgkmcnt(0)
    v_max3_f32 v8, v8, v10, v12
    v_max3_f32 v9, v9, v11, v13
    v_pk_add_f32 v[16:17], v[12:13], v[14:15]
    s_cmp_lg_u32 s34, 3
    v_pk_add_f32 v[4:5], v[4:5], v[16:17]
    s_cbranch_scc1 L_notlast
    v_max_f32_dpp v4, v8, v14 quad_perm:[0,1,2,3] row_mask:0xf bank_mask:0xc
    v_max_f32_dpp v5, v9, v15 quad_perm:[0,1,2,3] row_mask:0xf bank_mask:0xc
    v_and_or_b32 v4, v4, -16, v31
    v_and_or_b32 v5, v5, v33, v32
    buffer_store_dwordx2 v[4:5], v30, s[12:15], s43 offen
L_notlast:
    v_lshrrev_b32 v20, 4, v1
    s_cmp_lt_u32 s42, 24
    s_cselect_b32 s31, s28, 0
    s_cmp_eq_u32 s31, 3
    s_cbranch_scc1 L_rsetup
    s_cmp_ge_u32 s28, 2
    s_barrier
    s_cbranch_scc1 L_nopub
    s_cmp_eq_u32 s28, 0
    s_cselect_b64 s[20:21], s[36:37], s[38:39]
    s_movk_i32 s22, 18432
    s_mov_b32 s23, 0x20000
    s_mul_i32 s34, s28, 18432
    s_addk_i32 s34, 8192
    s_mov_b32 s35, 0
    v_lshlrev_b32 v2, 4, v1
L_wloop:
    s_add_u32 m0, s34, s35
    s_nop 0
    buffer_load_dwordx4 v2, s[20:23], s35 offen offset:0 lds
    buffer_load_dwordx4 v2, s[20:23], s35 offen offset:1024 lds
    buffer_load_dwordx4 v2, s[20:23], s35 offen offset:2048 lds
    s_addk_i32 s35, 3072
    s_cmp_lt_u32 s35, 18432
    s_cbranch_scc1 L_wloop
L_nopub:
    s_cmp_lt_u32 s28, 3
    s_cbranch_scc1 L_spill
    s_branch L_barw
L_rsetup:
    v_lshrrev_b32 v2, 2, v1
    v_mul_u32_u24 v2, 1536, v2
    v_and_b32 v3, 3, v1
    v_lshl_add_u32 v37, v3, 4, v2
    s_and_b32 s34, s2, 7
    s_mul_i32 s24, s34, 49152
    s_lshl_b32 s35, s42, 6
    s_add_u32 s24, s24, s35
    s_add_u32 s25, s24, 24576
    s_and_b32 s35, s42, 1
    s_lshl1_add_u32 s34, s34, s35
    s_lshr_b32 s35, s42, 3
    s_lshr_b32 s20, s42, 1
    s_lshl2_add_u32 s35, s35, s20
    s_lshl4_add_u32 s35, s35, s34
    s_lshl_b32 s35, s35, 7
    s_add_u32 s20, s35, 393216
    v_lshrrev_b32 v2, 5, v1
    v_mul_u32_u24 v2, 6, v2
    v_bfe_u32 v3, v1, 4, 1
    v_add_lshl_u32 v2, v2, v3, 13
    v_and_b32 v3, 15, v1
    v_lshl_add_u32 v3, v3, 2, v2
    s_lshl4_add_u32 s34, s47, s41
    s_xor_b32 s33, s34, 0xff
    s_lshl_b32 s33, s33, 8
    s_or_b32 s34, s34, s33
    v_and_b32 v2, 12, v3
    v_bfe_u32 v23, s34, v2, 4
    s_mov_b32 s33, 48
    s_mov_b32 s46, 0
    s_barrier
L_rpoll:
    buffer_load_dwordx4 v[4:7], v37, s[12:15], s24 offen sc1
    buffer_load_dwordx4 v[8:11], v37, s[12:15], s25 offen sc1
    s_sub_u32 s33, s33, 1
    s_cbranch_scc1 L_rlong
    s_waitcnt vmcnt(1)
    v_xor_b32 v4, s41, v4
    v_xor_b32 v5, s47, v5
    v_xor_b32 v6, s3, v6
    v_xor_b32 v7, s0, v7
    v_or3_b32 v21, v4, v5, v6
    v_or_b32 v21, v21, v7
    s_waitcnt vmcnt(0)
    v_xor_b32 v8, s41, v8
    v_xor_b32 v9, s47, v9
    v_xor_b32 v10, s3, v10
    v_xor_b32 v11, s0, v11
    v_or3_b32 v21, v21, v8, v9
    v_or_b32 v22, v10, v11
    v_bitop3_b32 v21, v21, v22, 15 bitop3:0xa8
    v_cmp_ne_u32 vcc, 0, v21
    s_wqm_b64 exec, vcc
    s_cbranch_scc1 L_rpoll
L_rgot:
    s_mov_b64 exec, -1
    s_cmp_ge_u32 s42, 12
    s_cbranch_scc1 L_rmax
    v_add_f32 v4, v4, v8
    v_add_f32 v5, v5, v9
    v_add_f32 v6, v6, v10
    v_add_f32 v7, v7, v11
    v_add_f32_dpp v4, v4, v4 row_ror:8 row_mask:0xf bank_mask:0x3
    v_add_f32_dpp v5, v5, v5 row_ror:8 row_mask:0xf bank_mask:0x3
    v_add_f32_dpp v4, v6, v6 row_ror:8 row_mask:0xf bank_mask:0xc
    v_add_f32_dpp v5, v7, v7 row_ror:8 row_mask:0xf bank_mask:0xc
    s_nop 0
    v_add_f32_dpp v4, v4, v4 row_shl:4 row_mask:0xf bank_mask:0x5
    v_add_f32_dpp v4, v5, v5 row_shr:4 row_mask:0xf bank_mask:0xa
    v_mov_b32 v5, v4
    s_nop 1
    v_permlane16_swap_b32 v4, v5
    v_add_f32 v4, v4, v5
    v_mov_b32 v5, v4
    s_nop 1
    v_permlane32_swap_b32 v4, v5
    v_add_f32 v4, v4, v5
    s_branch L_rpub
L_rmax:
    v_max_f32 v4, v4, v8
    v_max_f32 v5, v5, v9
    v_max_f32 v6, v6, v10
    v_max_f32 v7, v7, v11
    v_max_f32_dpp v4, v4, v4 row_ror:8 row_mask:0xf bank_mask:0x3
    v_max_f32_dpp v5, v5, v5 row_ror:8 row_mask:0xf bank_mask:0x3
    v_max_f32_dpp v4, v6, v6 row_ror:8 row_mask:0xf bank_mask:0xc
    v_max_f32_dpp v5, v7, v7 row_ror:8 row_mask:0xf bank_mask:0xc
    s_nop 0
    v_max_f32_dpp v4, v4, v4 row_shl:4 row_mask:0xf bank_mask:0x5
    v_max_f32_dpp v4, v5, v5 row_shr:4 row_mask:0xf bank_mask:0xa
    v_mov_b32 v5, v4
    s_nop 1
    v_permlane16_swap_b32 v4, v5
    v_max_f32 v4, v4, v5
    v_mov_b32 v5, v4
    s_nop 1
    v_permlane32_swap_b32 v4, v5
    v_max_f32 v4, v4, v5
L_rpub:
    v_and_or_b32 v4, v4, -16, v23
    buffer_store_dword v4, v3, s[12:15], s20 offen sc1
    s_barrier
    s_branch L_afterw
L_spill:
    s_lshl_b32 s34, s28, 13
    v_lshl_add_u32 v36, v1, 4, s34
    ds_write_b128 v36, v[136:139] offset:45056
    ds_write_b128 v36, v[140:143] offset:46080
    ds_write_b128 v36, v[144:147] offset:47104
    ds_write_b128 v36, v[148:151] offset:48128
    ds_write_b128 v36, v[152:155] offset:49152
    ds_write_b128 v36, v[156:159] offset:50176
    ds_write_b128 v36, v[160:163] offset:51200
    ds_write_b128 v36, v[164:167] offset:52224
L_barw:
    s_waitcnt vmcnt(0) lgkmcnt(0)
    s_barrier
L_afterw:
    v_bfe_u32 v3, v1, 2, 2
    v_lshl_add_u32 v21, v20, 3, v3
    v_and_b32 v22, 15, v21
    v_and_b32 v3, 3, v1
    s_lshl_b32 s51, s28, 5
    v_lshl_add_u32 v23, v3, 3, s51
    v_mov_b32 v3, 384
    v_mad_u32_u24 v2, v21, v3, v23
    v_mad_u32_u24 v22, v22, v3, v23
    ds_read_b64_tr_b16 v[28:29], v2 offset:26624
    ds_read_b64_tr_b16 v[30:31], v2 offset:28160
    ds_read_b64_tr_b16 v[32:33], v22 offset:38912
    ds_read_b64_tr_b16 v[34:35], v22 offset:40448
    v_and_b32 v2, 1, v1
    v_mul_u32_u24 v22, 96, v2
    v_lshl_add_u32 v24, v20, 4, v22
    v_and_b32 v3, 1, v20
    v_lshl_add_u32 v25, v3, 4, v22
    s_lshl_b32 s34, s28, 6
    v_lshl_add_u32 v26, v1, 2, s34
    v_mov_b32 v3, 0
    s_mov_b64 exec, 0xffff
    ds_write_b32 v26, v3 offset:6400
    s_mov_b64 exec, -1
    v_lshl_add_u32 v26, v2, 1, v26
    v_and_b32 v3, 7, v1
    s_lshl_b32 s34, s29, 8
    v_lshl_add_u32 v27, v3, 5, s34
    s_waitcnt lgkmcnt(0)
    s_mov_b32 exec_lo, 0
    v_mov_b32 v32, 0
    v_mov_b32 v33, 0
    v_mov_b32 v34, 0
    v_mov_b32 v35, 0
    s_mov_b64 exec, -1
    s_cmp_ge_u32 s28, 3
    s_cbranch_scc1 L_noa1
    v_mov_b32 v3, 96
    v_mad_u32_u24 v2, v21, v3, v23
    ds_read_b64_tr_b16 v[144:145], v2 offset:8192
    ds_read_b64_tr_b16 v[146:147], v2 offset:8576
    ds_read_b64_tr_b16 v[148:149], v2 offset:11264
    ds_read_b64_tr_b16 v[150:151], v2 offset:11648
    ds_read_b64_tr_b16 v[152:153], v2 offset:14336
    ds_read_b64_tr_b16 v[154:155], v2 offset:14720
    ds_read_b64_tr_b16 v[156:157], v2 offset:17408
    ds_read_b64_tr_b16 v[158:159], v2 offset:17792
    ds_read_b64_tr_b16 v[160:161], v2 offset:20480
    ds_read_b64_tr_b16 v[162:163], v2 offset:20864
    ds_read_b64_tr_b16 v[164:165], v2 offset:23552
    ds_read_b64_tr_b16 v[166:167], v2 offset:23936
L_noa1:
    v_lshl_add_u32 v3, v20, 3, v22
    v_add_u32 v3, s51, v3
    v_lshlrev_b32 v2, 2, v22
    v_lshl_add_u32 v2, v20, 4, v2
    v_bfe_u32 v8, v1, 2, 1
    v_lshl_add_u32 v8, v8, 2, v20
    v_and_b32 v9, 3, v1
    v_lshl_add_u32 v8, v8, 2, v9
    v_bfe_u32 v9, v8, 1, 3
    v_lshrrev_b32 v11, 4, v8
    v_and_b32 v8, 1, v8
    v_lshl_add_u32 v8, v11, 1, v8
    v_lshl_add_u32 v8, v9, 3, v8
    s_lshr_b32 s34, s28, 1
    s_and_b32 s35, s28, 1
    s_lshl4_add_u32 s34, s34, s35
    s_lshl_b32 s34, s34, 2
    v_add_lshl_u32 v23, v8, s34, 1
    v_lshrrev_b32 v8, 2, v1
    v_lshlrev_b32 v8, 7, v8
    v_and_b32 v9, 3, v1
    v_lshl_add_u32 v37, v9, 4, v8
    s_and_b32 s34, s1, 4
    s_and_b32 s33, s1, 1
    s_mul_i32 s33, s33, 24
    s_add_u32 s34, s34, s33
    s_lshr_b32 s35, s28, 2
    s_lshl2_add_u32 s35, s35, s28
    s_add_u32 s35, s35, s34
    s_lshl_b32 s35, s35, 11
    s_add_u32 s35, s35, 393216
    v_mov_b32 v16, s41
    v_mov_b32 v17, s47
    v_mov_b32 v18, s3
    v_mov_b32 v19, s0
    v_lshlrev_b32 v22, 4, v1
    s_lshl_b32 s24, s28, 7
    s_add_u32 s24, s24, s43
    s_mov_b32 s33, 48
    s_mov_b32 s46, 0
    s_cmp_lt_u32 s28, 6
    s_cbranch_scc1 L_qpoll0
L_qpoll1:
    buffer_load_dwordx4 v[4:7], v37, s[12:15], s35 offen sc1
    s_sub_u32 s33, s33, 1
    s_cbranch_scc1 L_qlong1
    s_waitcnt vmcnt(0)
    v_xor_b32 v4, s41, v4
    v_xor_b32 v5, s47, v5
    v_xor_b32 v6, s3, v6
    v_xor_b32 v7, s0, v7
    v_or3_b32 v21, v4, v5, v6
    v_bitop3_b32 v21, v21, v7, 15 bitop3:0xa8
    v_cmp_ne_u32 vcc, 0, v21
    s_wqm_b64 exec, vcc
    s_cbranch_scc1 L_qpoll1
L_qgot1:
    s_mov_b64 exec, -1
    v_permlane32_swap_b32 v4, v6
    v_permlane32_swap_b32 v5, v7
    v_max_f32 v4, v4, v6
    v_max_f32 v5, v5, v7
    s_nop 1
    v_permlane16_swap_b32 v4, v5
    v_max_f32 v4, v4, v5
    s_cmp_ge_u32 s28, 3
    s_nop 0
    v_max_f32_dpp v4, v4, v4 row_ror:8 row_mask:0xf bank_mask:0xf
    v_cvt_pk_bf16_f32 v4, v4, v4
    ds_write_b16 v23, v4 offset:7168
    s_waitcnt lgkmcnt(0)
    s_barrier
    s_mov_b64 exec, 0xff
    buffer_store_dwordx4 v[16:19], v22, s[12:15], s24 offen sc1
    s_mov_b64 exec, -1
    s_branch L_join
L_qpoll0:
    buffer_load_dwordx4 v[4:7], v37, s[12:15], s35 offen sc1
    s_sub_u32 s33, s33, 1
    s_cbranch_scc1 L_qlong0
    s_waitcnt vmcnt(0)
    v_xor_b32 v4, s41, v4
    v_xor_b32 v5, s47, v5
    v_xor_b32 v6, s3, v6
    v_xor_b32 v7, s0, v7
    v_or3_b32 v21, v4, v5, v6
    v_bitop3_b32 v21, v21, v7, 15 bitop3:0xa8
    v_cmp_ne_u32 vcc, 0, v21
    s_wqm_b64 exec, vcc
    s_cbranch_scc1 L_qpoll0
L_qgot0:
    s_mov_b64 exec, -1
    v_permlane32_swap_b32 v4, v6
    v_permlane32_swap_b32 v5, v7
    v_add_f32 v4, v4, v6
    v_add_f32 v5, v5, v7
    s_nop 1
    v_permlane16_swap_b32 v4, v5
    v_add_f32 v4, v4, v5
    s_cmp_ge_u32 s28, 3
    s_nop 0
    v_add_f32_dpp v4, v4, v4 row_ror:8 row_mask:0xf bank_mask:0xf
    v_mul_f32 v4, 0x36800000, v4
    v_cvt_pk_bf16_f32 v4, v4, v4
    ds_write_b16 v23, v4 offset:7168
    s_mov_b64 exec, 0xff
    buffer_store_dwordx4 v[16:19], v22, s[12:15], s24 offen sc1
    s_mov_b64 exec, -1
    s_waitcnt lgkmcnt(0)
    s_barrier
    s_cbranch_scc1 L_join
L_mlp1:
    ds_read_b128 v[4:7], v2 offset:7168
    ds_read_b128 v[8:11], v2 offset:7232
    ds_read_b128 v[12:15], v2 offset:7296
    ds_read_b128 v[16:19], v2 offset:7360
    ds_read_b128 v[136:139], v2 offset:7424
    ds_read_b128 v[140:143], v2 offset:7488
    s_waitcnt lgkmcnt(5)
    v_mfma_f32_16x16x32_bf16 v[20:23], v[144:147], v[4:7], 0
    s_waitcnt lgkmcnt(4)
    v_mfma_f32_16x16x32_bf16 v[20:23], v[148:151], v[8:11], v[20:23]
    s_waitcnt lgkmcnt(3)
    v_mfma_f32_16x16x32_bf16 v[20:23], v[152:155], v[12:15], v[20:23]
    s_waitcnt lgkmcnt(2)
    v_mfma_f32_16x16x32_bf16 v[20:23], v[156:159], v[16:19], v[20:23]
    s_waitcnt lgkmcnt(1)
    v_mfma_f32_16x16x32_bf16 v[20:23], v[160:163], v[136:139], v[20:23]
    s_waitcnt lgkmcnt(0)
    v_mfma_f32_16x16x32_bf16 v[20:23], v[164:167], v[140:143], v[20:23]
    s_nop 3
    s_mov_b32 exec_lo, 0x00030003
    s_mov_b32 exec_hi, 0x00030003
    s_nop 1
    v_maximum3_f32 v20, v20, 0, 0
    v_maximum3_f32 v21, v21, 0, 0
    v_maximum3_f32 v22, v22, 0, 0
    v_maximum3_f32 v23, v23, 0, 0
    v_cvt_pk_bf16_f32 v20, v20, v21
    v_cvt_pk_bf16_f32 v21, v22, v23
    ds_write_b64 v3, v[20:21] offset:6144
    s_mov_b64 exec, -1
    s_waitcnt lgkmcnt(0)
L_join:
    s_barrier
    ds_read_b128 v[4:7], v24 offset:6144
    ds_read_b128 v[8:11], v25 offset:6208
    s_waitcnt lgkmcnt(1)
    v_mfma_f32_16x16x32_bf16 v[12:15], v[4:7], v[28:31], 0
    s_waitcnt lgkmcnt(0)
    v_mfma_f32_16x16x32_bf16 v[12:15], v[8:11], v[32:35], v[12:15]
    s_mov_b64 exec, 0xffff
    s_nop 6
    v_cvt_pk_bf16_f32 v12, 0, v12
    v_cvt_pk_bf16_f32 v13, 0, v13
    v_add_f32 v12, v12, v13
    v_cvt_pk_bf16_f32 v12, 0, v12
    v_mul_f32 v12, 0xbfb8aa3b, v12
    v_exp_f32 v12, v12
    s_nop 0
    v_add_f32 v12, 1.0, v12
    v_rcp_f32 v12, v12
    s_nop 0
    v_cvt_pk_bf16_f32 v12, v12, v12
    ds_write_b16 v26, v12 offset:6400
    s_mov_b64 exec, -1
    s_waitcnt lgkmcnt(0)
    s_barrier
    ds_read_b128 v[4:7], v27 offset:6400
    ds_read_b128 v[8:11], v27 offset:6416
    s_waitcnt lgkmcnt(0)
    v_dot2_f32_bf16 v12, v40, v4, 0
    v_dot2_f32_bf16 v13, v40, v5, 0
    v_dot2_f32_bf16 v14, v41, v6, 0
    v_dot2_f32_bf16 v15, v41, v7, 0
    v_dot2_f32_bf16 v16, v42, v8, 0
    v_dot2_f32_bf16 v17, v42, v9, 0
    v_dot2_f32_bf16 v18, v43, v10, 0
    v_dot2_f32_bf16 v19, v43, v11, 0
    v_cvt_pk_bf16_f32 v40, v12, v13
    v_cvt_pk_bf16_f32 v41, v14, v15
    v_cvt_pk_bf16_f32 v42, v16, v17
    v_cvt_pk_bf16_f32 v43, v18, v19
    buffer_store_dwordx4 v[40:43], v0, s[8:11], s40 offen sc1
    v_dot2_f32_bf16 v20, v88, v4, 0
    v_dot2_f32_bf16 v21, v88, v5, 0
    v_dot2_f32_bf16 v22, v89, v6, 0
    v_dot2_f32_bf16 v23, v89, v7, 0
    v_dot2_f32_bf16 v24, v90, v8, 0
    v_dot2_f32_bf16 v25, v90, v9, 0
    v_dot2_f32_bf16 v26, v91, v10, 0
    v_dot2_f32_bf16 v27, v91, v11, 0
    v_cvt_pk_bf16_f32 v88, v20, v21
    v_cvt_pk_bf16_f32 v89, v22, v23
    v_cvt_pk_bf16_f32 v90, v24, v25
    v_cvt_pk_bf16_f32 v91, v26, v27
    s_bitcmp1_b32 s49, 6
    s_cselect_b32 s50, 24576, 0
    s_add_u32 s31, s48, 37748736
    v_xad_u32 v2, v39, s50, v0
    buffer_store_dwordx4 v[88:91], v2, s[8:11], s31 offen sc1
    s_cmp_ge_u32 s28, 3
    s_cbranch_scc1 L_norestore
    ds_read_b128 v[136:139], v36 offset:45056
    ds_read_b128 v[140:143], v36 offset:46080
    ds_read_b128 v[144:147], v36 offset:47104
    ds_read_b128 v[148:151], v36 offset:48128
    ds_read_b128 v[152:155], v36 offset:49152
    ds_read_b128 v[156:159], v36 offset:50176
    ds_read_b128 v[160:163], v36 offset:51200
    ds_read_b128 v[164:167], v36 offset:52224
L_norestore:
    v_dot2_f32_bf16 v12, v44, v4, 0
    v_dot2_f32_bf16 v13, v44, v5, 0
    v_dot2_f32_bf16 v14, v45, v6, 0
    v_dot2_f32_bf16 v15, v45, v7, 0
    v_dot2_f32_bf16 v16, v46, v8, 0
    v_dot2_f32_bf16 v17, v46, v9, 0
    v_dot2_f32_bf16 v18, v47, v10, 0
    v_dot2_f32_bf16 v19, v47, v11, 0
    v_cvt_pk_bf16_f32 v44, v12, v13
    v_cvt_pk_bf16_f32 v45, v14, v15
    v_cvt_pk_bf16_f32 v46, v16, v17
    v_cvt_pk_bf16_f32 v47, v18, v19
    s_add_u32 s31, s40, 12288
    buffer_store_dwordx4 v[44:47], v0, s[8:11], s31 offen sc1
    v_dot2_f32_bf16 v20, v92, v4, 0
    v_dot2_f32_bf16 v21, v92, v5, 0
    v_dot2_f32_bf16 v22, v93, v6, 0
    v_dot2_f32_bf16 v23, v93, v7, 0
    v_dot2_f32_bf16 v24, v94, v8, 0
    v_dot2_f32_bf16 v25, v94, v9, 0
    v_dot2_f32_bf16 v26, v95, v10, 0
    v_dot2_f32_bf16 v27, v95, v11, 0
    v_cvt_pk_bf16_f32 v92, v20, v21
    v_cvt_pk_bf16_f32 v93, v22, v23
    v_cvt_pk_bf16_f32 v94, v24, v25
    v_cvt_pk_bf16_f32 v95, v26, v27
    s_add_u32 s31, s48, 37761024
    v_xad_u32 v3, v38, s50, v0
    buffer_store_dwordx4 v[92:95], v3, s[8:11], s31 offen sc1
    v_dot2_f32_bf16 v12, v48, v4, 0
    v_dot2_f32_bf16 v13, v48, v5, 0
    v_dot2_f32_bf16 v14, v49, v6, 0
    v_dot2_f32_bf16 v15, v49, v7, 0
    v_dot2_f32_bf16 v16, v50, v8, 0
    v_dot2_f32_bf16 v17, v50, v9, 0
    v_dot2_f32_bf16 v18, v51, v10, 0
    v_dot2_f32_bf16 v19, v51, v11, 0
    v_cvt_pk_bf16_f32 v48, v12, v13
    v_cvt_pk_bf16_f32 v49, v14, v15
    v_cvt_pk_bf16_f32 v50, v16, v17
    v_cvt_pk_bf16_f32 v51, v18, v19
    s_add_u32 s31, s40, 24576
    buffer_store_dwordx4 v[48:51], v0, s[8:11], s31 offen sc1
    v_dot2_f32_bf16 v20, v96, v4, 0
    v_dot2_f32_bf16 v21, v96, v5, 0
    v_dot2_f32_bf16 v22, v97, v6, 0
    v_dot2_f32_bf16 v23, v97, v7, 0
    v_dot2_f32_bf16 v24, v98, v8, 0
    v_dot2_f32_bf16 v25, v98, v9, 0
    v_dot2_f32_bf16 v26, v99, v10, 0
    v_dot2_f32_bf16 v27, v99, v11, 0
    v_cvt_pk_bf16_f32 v96, v20, v21
    v_cvt_pk_bf16_f32 v97, v22, v23
    v_cvt_pk_bf16_f32 v98, v24, v25
    v_cvt_pk_bf16_f32 v99, v26, v27
    s_bitcmp1_b32 s49, 7
    s_cselect_b32 s50, 24576, 0
    s_add_u32 s31, s45, 37748736
    v_xad_u32 v2, v39, s50, v0
    buffer_store_dwordx4 v[96:99], v2, s[8:11], s31 offen sc1
    v_dot2_f32_bf16 v12, v52, v4, 0
    v_dot2_f32_bf16 v13, v52, v5, 0
    v_dot2_f32_bf16 v14, v53, v6, 0
    v_dot2_f32_bf16 v15, v53, v7, 0
    v_dot2_f32_bf16 v16, v54, v8, 0
    v_dot2_f32_bf16 v17, v54, v9, 0
    v_dot2_f32_bf16 v18, v55, v10, 0
    v_dot2_f32_bf16 v19, v55, v11, 0
    v_cvt_pk_bf16_f32 v52, v12, v13
    v_cvt_pk_bf16_f32 v53, v14, v15
    v_cvt_pk_bf16_f32 v54, v16, v17
    v_cvt_pk_bf16_f32 v55, v18, v19
    s_add_u32 s31, s40, 36864
    buffer_store_dwordx4 v[52:55], v0, s[8:11], s31 offen sc1
    v_dot2_f32_bf16 v20, v100, v4, 0
    v_dot2_f32_bf16 v21, v100, v5, 0
    v_dot2_f32_bf16 v22, v101, v6, 0
    v_dot2_f32_bf16 v23, v101, v7, 0
    v_dot2_f32_bf16 v24, v102, v8, 0
    v_dot2_f32_bf16 v25, v102, v9, 0
    v_dot2_f32_bf16 v26, v103, v10, 0
    v_dot2_f32_bf16 v27, v103, v11, 0
    v_cvt_pk_bf16_f32 v100, v20, v21
    v_cvt_pk_bf16_f32 v101, v22, v23
    v_cvt_pk_bf16_f32 v102, v24, v25
    v_cvt_pk_bf16_f32 v103, v26, v27
    s_add_u32 s31, s45, 37761024
    v_xad_u32 v3, v38, s50, v0
    buffer_store_dwordx4 v[100:103], v3, s[8:11], s31 offen sc1
    v_dot2_f32_bf16 v12, v56, v4, 0
    v_dot2_f32_bf16 v13, v56, v5, 0
    v_dot2_f32_bf16 v14, v57, v6, 0
    v_dot2_f32_bf16 v15, v57, v7, 0
    v_dot2_f32_bf16 v16, v58, v8, 0
    v_dot2_f32_bf16 v17, v58, v9, 0
    v_dot2_f32_bf16 v18, v59, v10, 0
    v_dot2_f32_bf16 v19, v59, v11, 0
    v_cvt_pk_bf16_f32 v56, v12, v13
    v_cvt_pk_bf16_f32 v57, v14, v15
    v_cvt_pk_bf16_f32 v58, v16, v17
    v_cvt_pk_bf16_f32 v59, v18, v19
    s_add_u32 s31, s40, 12582912
    buffer_store_dwordx4 v[56:59], v0, s[8:11], s31 offen sc1
    v_dot2_f32_bf16 v20, v104, v4, 0
    v_dot2_f32_bf16 v21, v104, v5, 0
    v_dot2_f32_bf16 v22, v105, v6, 0
    v_dot2_f32_bf16 v23, v105, v7, 0
    v_dot2_f32_bf16 v24, v106, v8, 0
    v_dot2_f32_bf16 v25, v106, v9, 0
    v_dot2_f32_bf16 v26, v107, v10, 0
    v_dot2_f32_bf16 v27, v107, v11, 0
    v_cvt_pk_bf16_f32 v104, v20, v21
    v_cvt_pk_bf16_f32 v105, v22, v23
    v_cvt_pk_bf16_f32 v106, v24, v25
    v_cvt_pk_bf16_f32 v107, v26, v27
    s_bitcmp1_b32 s49, 8
    s_cselect_b32 s50, 24576, 0
    s_add_u32 s31, s48, 50331648
    v_xad_u32 v2, v39, s50, v0
    buffer_store_dwordx4 v[104:107], v2, s[8:11], s31 offen sc1
    v_dot2_f32_bf16 v12, v60, v4, 0
    v_dot2_f32_bf16 v13, v60, v5, 0
    v_dot2_f32_bf16 v14, v61, v6, 0
    v_dot2_f32_bf16 v15, v61, v7, 0
    v_dot2_f32_bf16 v16, v62, v8, 0
    v_dot2_f32_bf16 v17, v62, v9, 0
    v_dot2_f32_bf16 v18, v63, v10, 0
    v_dot2_f32_bf16 v19, v63, v11, 0
    v_cvt_pk_bf16_f32 v60, v12, v13
    v_cvt_pk_bf16_f32 v61, v14, v15
    v_cvt_pk_bf16_f32 v62, v16, v17
    v_cvt_pk_bf16_f32 v63, v18, v19
    s_add_u32 s31, s40, 12595200
    buffer_store_dwordx4 v[60:63], v0, s[8:11], s31 offen sc1
    v_dot2_f32_bf16 v20, v108, v4, 0
    v_dot2_f32_bf16 v21, v108, v5, 0
    v_dot2_f32_bf16 v22, v109, v6, 0
    v_dot2_f32_bf16 v23, v109, v7, 0
    v_dot2_f32_bf16 v24, v110, v8, 0
    v_dot2_f32_bf16 v25, v110, v9, 0
    v_dot2_f32_bf16 v26, v111, v10, 0
    v_dot2_f32_bf16 v27, v111, v11, 0
    v_cvt_pk_bf16_f32 v108, v20, v21
    v_cvt_pk_bf16_f32 v109, v22, v23
    v_cvt_pk_bf16_f32 v110, v24, v25
    v_cvt_pk_bf16_f32 v111, v26, v27
    s_add_u32 s31, s48, 50343936
    v_xad_u32 v3, v38, s50, v0
    buffer_store_dwordx4 v[108:111], v3, s[8:11], s31 offen sc1
    v_dot2_f32_bf16 v12, v64, v4, 0
    v_dot2_f32_bf16 v13, v64, v5, 0
    v_dot2_f32_bf16 v14, v65, v6, 0
    v_dot2_f32_bf16 v15, v65, v7, 0
    v_dot2_f32_bf16 v16, v66, v8, 0
    v_dot2_f32_bf16 v17, v66, v9, 0
    v_dot2_f32_bf16 v18, v67, v10, 0
    v_dot2_f32_bf16 v19, v67, v11, 0
    v_cvt_pk_bf16_f32 v64, v12, v13
    v_cvt_pk_bf16_f32 v65, v14, v15
    v_cvt_pk_bf16_f32 v66, v16, v17
    v_cvt_pk_bf16_f32 v67, v18, v19
    s_add_u32 s31, s40, 12607488
    buffer_store_dwordx4 v[64:67], v0, s[8:11], s31 offen sc1
    v_dot2_f32_bf16 v20, v112, v4, 0
    v_dot2_f32_bf16 v21, v112, v5, 0
    v_dot2_f32_bf16 v22, v113, v6, 0
    v_dot2_f32_bf16 v23, v113, v7, 0
    v_dot2_f32_bf16 v24, v114, v8, 0
    v_dot2_f32_bf16 v25, v114, v9, 0
    v_dot2_f32_bf16 v26, v115, v10, 0
    v_dot2_f32_bf16 v27, v115, v11, 0
    v_cvt_pk_bf16_f32 v112, v20, v21
    v_cvt_pk_bf16_f32 v113, v22, v23
    v_cvt_pk_bf16_f32 v114, v24, v25
    v_cvt_pk_bf16_f32 v115, v26, v27
    s_bitcmp1_b32 s49, 9
    s_cselect_b32 s50, 24576, 0
    s_add_u32 s31, s45, 50331648
    v_xad_u32 v2, v39, s50, v0
    buffer_store_dwordx4 v[112:115], v2, s[8:11], s31 offen sc1
    v_dot2_f32_bf16 v12, v68, v4, 0
    v_dot2_f32_bf16 v13, v68, v5, 0
    v_dot2_f32_bf16 v14, v69, v6, 0
    v_dot2_f32_bf16 v15, v69, v7, 0
    v_dot2_f32_bf16 v16, v70, v8, 0
    v_dot2_f32_bf16 v17, v70, v9, 0
    v_dot2_f32_bf16 v18, v71, v10, 0
    v_dot2_f32_bf16 v19, v71, v11, 0
    v_cvt_pk_bf16_f32 v68, v12, v13
    v_cvt_pk_bf16_f32 v69, v14, v15
    v_cvt_pk_bf16_f32 v70, v16, v17
    v_cvt_pk_bf16_f32 v71, v18, v19
    s_add_u32 s31, s40, 12619776
    buffer_store_dwordx4 v[68:71], v0, s[8:11], s31 offen sc1
    v_dot2_f32_bf16 v20, v116, v4, 0
    v_dot2_f32_bf16 v21, v116, v5, 0
    v_dot2_f32_bf16 v22, v117, v6, 0
    v_dot2_f32_bf16 v23, v117, v7, 0
    v_dot2_f32_bf16 v24, v118, v8, 0
    v_dot2_f32_bf16 v25, v118, v9, 0
    v_dot2_f32_bf16 v26, v119, v10, 0
    v_dot2_f32_bf16 v27, v119, v11, 0
    v_cvt_pk_bf16_f32 v116, v20, v21
    v_cvt_pk_bf16_f32 v117, v22, v23
    v_cvt_pk_bf16_f32 v118, v24, v25
    v_cvt_pk_bf16_f32 v119, v26, v27
    s_add_u32 s31, s45, 50343936
    v_xad_u32 v3, v38, s50, v0
    buffer_store_dwordx4 v[116:119], v3, s[8:11], s31 offen sc1
    v_dot2_f32_bf16 v12, v72, v4, 0
    v_dot2_f32_bf16 v13, v72, v5, 0
    v_dot2_f32_bf16 v14, v73, v6, 0
    v_dot2_f32_bf16 v15, v73, v7, 0
    v_dot2_f32_bf16 v16, v74, v8, 0
    v_dot2_f32_bf16 v17, v74, v9, 0
    v_dot2_f32_bf16 v18, v75, v10, 0
    v_dot2_f32_bf16 v19, v75, v11, 0
    v_cvt_pk_bf16_f32 v72, v12, v13
    v_cvt_pk_bf16_f32 v73, v14, v15
    v_cvt_pk_bf16_f32 v74, v16, v17
    v_cvt_pk_bf16_f32 v75, v18, v19
    s_add_u32 s31, s40, 25165824
    buffer_store_dwordx4 v[72:75], v0, s[8:11], s31 offen sc1
    v_dot2_f32_bf16 v20, v120, v4, 0
    v_dot2_f32_bf16 v21, v120, v5, 0
    v_dot2_f32_bf16 v22, v121, v6, 0
    v_dot2_f32_bf16 v23, v121, v7, 0
    v_dot2_f32_bf16 v24, v122, v8, 0
    v_dot2_f32_bf16 v25, v122, v9, 0
    v_dot2_f32_bf16 v26, v123, v10, 0
    v_dot2_f32_bf16 v27, v123, v11, 0
    v_cvt_pk_bf16_f32 v120, v20, v21
    v_cvt_pk_bf16_f32 v121, v22, v23
    v_cvt_pk_bf16_f32 v122, v24, v25
    v_cvt_pk_bf16_f32 v123, v26, v27
    s_bitcmp1_b32 s49, 10
    s_cselect_b32 s50, 24576, 0
    s_add_u32 s31, s48, 62914560
    v_xad_u32 v2, v39, s50, v0
    buffer_store_dwordx4 v[120:123], v2, s[8:11], s31 offen sc1
    v_dot2_f32_bf16 v12, v76, v4, 0
    v_dot2_f32_bf16 v13, v76, v5, 0
    v_dot2_f32_bf16 v14, v77, v6, 0
    v_dot2_f32_bf16 v15, v77, v7, 0
    v_dot2_f32_bf16 v16, v78, v8, 0
    v_dot2_f32_bf16 v17, v78, v9, 0
    v_dot2_f32_bf16 v18, v79, v10, 0
    v_dot2_f32_bf16 v19, v79, v11, 0
    v_cvt_pk_bf16_f32 v76, v12, v13
    v_cvt_pk_bf16_f32 v77, v14, v15
    v_cvt_pk_bf16_f32 v78, v16, v17
    v_cvt_pk_bf16_f32 v79, v18, v19
    s_add_u32 s31, s40, 25178112
    buffer_store_dwordx4 v[76:79], v0, s[8:11], s31 offen sc1
    v_dot2_f32_bf16 v20, v124, v4, 0
    v_dot2_f32_bf16 v21, v124, v5, 0
    v_dot2_f32_bf16 v22, v125, v6, 0
    v_dot2_f32_bf16 v23, v125, v7, 0
    v_dot2_f32_bf16 v24, v126, v8, 0
    v_dot2_f32_bf16 v25, v126, v9, 0
    v_dot2_f32_bf16 v26, v127, v10, 0
    v_dot2_f32_bf16 v27, v127, v11, 0
    v_cvt_pk_bf16_f32 v124, v20, v21
    v_cvt_pk_bf16_f32 v125, v22, v23
    v_cvt_pk_bf16_f32 v126, v24, v25
    v_cvt_pk_bf16_f32 v127, v26, v27
    s_add_u32 s31, s48, 62926848
    v_xad_u32 v3, v38, s50, v0
    buffer_store_dwordx4 v[124:127], v3, s[8:11], s31 offen sc1
    v_dot2_f32_bf16 v12, v80, v4, 0
    v_dot2_f32_bf16 v13, v80, v5, 0
    v_dot2_f32_bf16 v14, v81, v6, 0
    v_dot2_f32_bf16 v15, v81, v7, 0
    v_dot2_f32_bf16 v16, v82, v8, 0
    v_dot2_f32_bf16 v17, v82, v9, 0
    v_dot2_f32_bf16 v18, v83, v10, 0
    v_dot2_f32_bf16 v19, v83, v11, 0
    v_cvt_pk_bf16_f32 v80, v12, v13
    v_cvt_pk_bf16_f32 v81, v14, v15
    v_cvt_pk_bf16_f32 v82, v16, v17
    v_cvt_pk_bf16_f32 v83, v18, v19
    s_add_u32 s31, s40, 25190400
    buffer_store_dwordx4 v[80:83], v0, s[8:11], s31 offen sc1
    v_dot2_f32_bf16 v20, v128, v4, 0
    v_dot2_f32_bf16 v21, v128, v5, 0
    v_dot2_f32_bf16 v22, v129, v6, 0
    v_dot2_f32_bf16 v23, v129, v7, 0
    v_dot2_f32_bf16 v24, v130, v8, 0
    v_dot2_f32_bf16 v25, v130, v9, 0
    v_dot2_f32_bf16 v26, v131, v10, 0
    v_dot2_f32_bf16 v27, v131, v11, 0
    v_cvt_pk_bf16_f32 v128, v20, v21
    v_cvt_pk_bf16_f32 v129, v22, v23
    v_cvt_pk_bf16_f32 v130, v24, v25
    v_cvt_pk_bf16_f32 v131, v26, v27
    s_bitcmp1_b32 s49, 11
    s_cselect_b32 s50, 24576, 0
    s_add_u32 s31, s45, 62914560
    v_xad_u32 v2, v39, s50, v0
    buffer_store_dwordx4 v[128:131], v2, s[8:11], s31 offen sc1
    v_dot2_f32_bf16 v12, v84, v4, 0
    v_dot2_f32_bf16 v13, v84, v5, 0
    v_dot2_f32_bf16 v14, v85, v6, 0
    v_dot2_f32_bf16 v15, v85, v7, 0
    v_dot2_f32_bf16 v16, v86, v8, 0
    v_dot2_f32_bf16 v17, v86, v9, 0
    v_dot2_f32_bf16 v18, v87, v10, 0
    v_dot2_f32_bf16 v19, v87, v11, 0
    v_cvt_pk_bf16_f32 v84, v12, v13
    v_cvt_pk_bf16_f32 v85, v14, v15
    v_cvt_pk_bf16_f32 v86, v16, v17
    v_cvt_pk_bf16_f32 v87, v18, v19
    s_add_u32 s31, s40, 25202688
    buffer_store_dwordx4 v[84:87], v0, s[8:11], s31 offen sc1
    v_dot2_f32_bf16 v20, v132, v4, 0
    v_dot2_f32_bf16 v21, v132, v5, 0
    v_dot2_f32_bf16 v22, v133, v6, 0
    v_dot2_f32_bf16 v23, v133, v7, 0
    v_dot2_f32_bf16 v24, v134, v8, 0
    v_dot2_f32_bf16 v25, v134, v9, 0
    v_dot2_f32_bf16 v26, v135, v10, 0
    v_dot2_f32_bf16 v27, v135, v11, 0
    v_cvt_pk_bf16_f32 v132, v20, v21
    v_cvt_pk_bf16_f32 v133, v22, v23
    v_cvt_pk_bf16_f32 v134, v24, v25
    v_cvt_pk_bf16_f32 v135, v26, v27
    s_add_u32 s31, s45, 62926848
    v_xad_u32 v3, v38, s50, v0
    buffer_store_dwordx4 v[132:135], v3, s[8:11], s31 offen sc1
    s_barrier
    s_waitcnt lgkmcnt(0)
    v_dot2_f32_bf16 v12, v136, v4, 0
    v_dot2_f32_bf16 v13, v136, v5, 0
    v_dot2_f32_bf16 v14, v137, v6, 0
    v_dot2_f32_bf16 v15, v137, v7, 0
    v_dot2_f32_bf16 v16, v138, v8, 0
    v_dot2_f32_bf16 v17, v138, v9, 0
    v_dot2_f32_bf16 v18, v139, v10, 0
    v_dot2_f32_bf16 v19, v139, v11, 0
    v_cvt_pk_bf16_f32 v136, v12, v13
    v_cvt_pk_bf16_f32 v137, v14, v15
    v_cvt_pk_bf16_f32 v138, v16, v17
    v_cvt_pk_bf16_f32 v139, v18, v19
    s_bitcmp1_b32 s49, 12
    s_cselect_b32 s50, 24576, 0
    s_add_u32 s31, s48, 75497472
    v_xad_u32 v2, v39, s50, v0
    buffer_store_dwordx4 v[136:139], v2, s[8:11], s31 offen sc1
    v_dot2_f32_bf16 v20, v140, v4, 0
    v_dot2_f32_bf16 v21, v140, v5, 0
    v_dot2_f32_bf16 v22, v141, v6, 0
    v_dot2_f32_bf16 v23, v141, v7, 0
    v_dot2_f32_bf16 v24, v142, v8, 0
    v_dot2_f32_bf16 v25, v142, v9, 0
    v_dot2_f32_bf16 v26, v143, v10, 0
    v_dot2_f32_bf16 v27, v143, v11, 0
    v_cvt_pk_bf16_f32 v140, v20, v21
    v_cvt_pk_bf16_f32 v141, v22, v23
    v_cvt_pk_bf16_f32 v142, v24, v25
    v_cvt_pk_bf16_f32 v143, v26, v27
    s_add_u32 s31, s48, 75509760
    v_xad_u32 v3, v38, s50, v0
    buffer_store_dwordx4 v[140:143], v3, s[8:11], s31 offen sc1
    v_dot2_f32_bf16 v12, v144, v4, 0
    v_dot2_f32_bf16 v13, v144, v5, 0
    v_dot2_f32_bf16 v14, v145, v6, 0
    v_dot2_f32_bf16 v15, v145, v7, 0
    v_dot2_f32_bf16 v16, v146, v8, 0
    v_dot2_f32_bf16 v17, v146, v9, 0
    v_dot2_f32_bf16 v18, v147, v10, 0
    v_dot2_f32_bf16 v19, v147, v11, 0
    v_cvt_pk_bf16_f32 v144, v12, v13
    v_cvt_pk_bf16_f32 v145, v14, v15
    v_cvt_pk_bf16_f32 v146, v16, v17
    v_cvt_pk_bf16_f32 v147, v18, v19
    s_bitcmp1_b32 s49, 13
    s_cselect_b32 s50, 24576, 0
    s_add_u32 s31, s45, 75497472
    v_xad_u32 v2, v39, s50, v0
    buffer_store_dwordx4 v[144:147], v2, s[8:11], s31 offen sc1
    v_dot2_f32_bf16 v20, v148, v4, 0
    v_dot2_f32_bf16 v21, v148, v5, 0
    v_dot2_f32_bf16 v22, v149, v6, 0
    v_dot2_f32_bf16 v23, v149, v7, 0
    v_dot2_f32_bf16 v24, v150, v8, 0
    v_dot2_f32_bf16 v25, v150, v9, 0
    v_dot2_f32_bf16 v26, v151, v10, 0
    v_dot2_f32_bf16 v27, v151, v11, 0
    v_cvt_pk_bf16_f32 v148, v20, v21
    v_cvt_pk_bf16_f32 v149, v22, v23
    v_cvt_pk_bf16_f32 v150, v24, v25
    v_cvt_pk_bf16_f32 v151, v26, v27
    s_add_u32 s31, s45, 75509760
    v_xad_u32 v3, v38, s50, v0
    buffer_store_dwordx4 v[148:151], v3, s[8:11], s31 offen sc1
    v_dot2_f32_bf16 v12, v152, v4, 0
    v_dot2_f32_bf16 v13, v152, v5, 0
    v_dot2_f32_bf16 v14, v153, v6, 0
    v_dot2_f32_bf16 v15, v153, v7, 0
    v_dot2_f32_bf16 v16, v154, v8, 0
    v_dot2_f32_bf16 v17, v154, v9, 0
    v_dot2_f32_bf16 v18, v155, v10, 0
    v_dot2_f32_bf16 v19, v155, v11, 0
    v_cvt_pk_bf16_f32 v152, v12, v13
    v_cvt_pk_bf16_f32 v153, v14, v15
    v_cvt_pk_bf16_f32 v154, v16, v17
    v_cvt_pk_bf16_f32 v155, v18, v19
    s_bitcmp1_b32 s49, 14
    s_cselect_b32 s50, 24576, 0
    s_add_u32 s31, s48, 88080384
    v_xad_u32 v2, v39, s50, v0
    buffer_store_dwordx4 v[152:155], v2, s[8:11], s31 offen sc1
    v_dot2_f32_bf16 v20, v156, v4, 0
    v_dot2_f32_bf16 v21, v156, v5, 0
    v_dot2_f32_bf16 v22, v157, v6, 0
    v_dot2_f32_bf16 v23, v157, v7, 0
    v_dot2_f32_bf16 v24, v158, v8, 0
    v_dot2_f32_bf16 v25, v158, v9, 0
    v_dot2_f32_bf16 v26, v159, v10, 0
    v_dot2_f32_bf16 v27, v159, v11, 0
    v_cvt_pk_bf16_f32 v156, v20, v21
    v_cvt_pk_bf16_f32 v157, v22, v23
    v_cvt_pk_bf16_f32 v158, v24, v25
    v_cvt_pk_bf16_f32 v159, v26, v27
    s_add_u32 s31, s48, 88092672
    v_xad_u32 v3, v38, s50, v0
    buffer_store_dwordx4 v[156:159], v3, s[8:11], s31 offen sc1
    v_dot2_f32_bf16 v12, v160, v4, 0
    v_dot2_f32_bf16 v13, v160, v5, 0
    v_dot2_f32_bf16 v14, v161, v6, 0
    v_dot2_f32_bf16 v15, v161, v7, 0
    v_dot2_f32_bf16 v16, v162, v8, 0
    v_dot2_f32_bf16 v17, v162, v9, 0
    v_dot2_f32_bf16 v18, v163, v10, 0
    v_dot2_f32_bf16 v19, v163, v11, 0
    v_cvt_pk_bf16_f32 v160, v12, v13
    v_cvt_pk_bf16_f32 v161, v14, v15
    v_cvt_pk_bf16_f32 v162, v16, v17
    v_cvt_pk_bf16_f32 v163, v18, v19
    s_bitcmp1_b32 s49, 15
    s_cselect_b32 s50, 24576, 0
    s_add_u32 s31, s45, 88080384
    v_xad_u32 v2, v39, s50, v0
    v_add_u32 v2, s31, v2
    v_subrev_u32 v3, s6, v2
    v_min_u32 v2, v2, v3
    buffer_store_dwordx4 v[160:163], v2, s[8:11], 0 offen sc1
    v_dot2_f32_bf16 v20, v164, v4, 0
    v_dot2_f32_bf16 v21, v164, v5, 0
    v_dot2_f32_bf16 v22, v165, v6, 0
    v_dot2_f32_bf16 v23, v165, v7, 0
    v_dot2_f32_bf16 v24, v166, v8, 0
    v_dot2_f32_bf16 v25, v166, v9, 0
    v_dot2_f32_bf16 v26, v167, v10, 0
    v_dot2_f32_bf16 v27, v167, v11, 0
    v_cvt_pk_bf16_f32 v164, v20, v21
    v_cvt_pk_bf16_f32 v165, v22, v23
    v_cvt_pk_bf16_f32 v166, v24, v25
    v_cvt_pk_bf16_f32 v167, v26, v27
    s_add_u32 s31, s45, 88092672
    v_xad_u32 v3, v38, s50, v0
    v_add_u32 v3, s31, v3
    v_subrev_u32 v2, s6, v3
    v_min_u32 v3, v3, v2
    buffer_store_dwordx4 v[164:167], v3, s[8:11], 0 offen sc1
L_end:
    s_endpgm
.section .rodata,"a"
.p2align 6
.amdhsa_kernel standalone__channel_attn_cbam__vision_kernel
  .amdhsa_next_free_vgpr 168
  .amdhsa_next_free_sgpr 56
  .amdhsa_accum_offset 168
  .amdhsa_group_segment_fixed_size 0
  .amdhsa_kernarg_size 48
  .amdhsa_user_sgpr_count 2
  .amdhsa_user_sgpr_kernarg_segment_ptr 1
  .amdhsa_system_sgpr_workgroup_id_x 1
  .amdhsa_float_denorm_mode_32 3
.end_amdhsa_kernel
```
